```python
import torch

def _softmax(x, axis=-1):
    return torch.softmax(x, dim=axis)
def _gelu(x):
    return torch.nn.functional.gelu(x, approximate="tanh")
def _silu(x):
    return torch.nn.functional.silu(x)
def _sigmoid(x):
    return torch.sigmoid(x)
def _layernorm(x, axis=-1, eps=1e-5):
    m = x.mean(dim=axis, keepdim=True)
    v = x.var(dim=axis, keepdim=True, unbiased=False)
    return (x - m) / torch.sqrt(v + eps)
def _scatter_add(tgt, idx, src, axis=0):
    return tgt.clone().index_add_(axis, idx, src)
def _segment_sum(src, seg, n):
    out = torch.zeros((n,) + src.shape[1:], dtype=src.dtype)
    return out.index_add_(0, seg, src)
def _pad(x, pw):
    flat = tuple(v for pair in reversed(pw) for v in pair)
    return torch.nn.functional.pad(x, flat)

kernel_name = 'standalone__gqa_softmax__near_ridge'

def setup_inputs():

    _w = (lambda a: (lambda t: t.to(torch.bfloat16) if t.is_floating_point() else t)(torch.as_tensor(a)))
    B, Hq, Hkv, Sq, Sk, D = 64, 32, 8, 256, 256, 128
    return {
        "q": _w((lambda *s: torch.randn(*s, dtype=torch.bfloat16) * 0.8)(B, Hq, Sq, D)),
        "k": _w((lambda *s: torch.randn(*s, dtype=torch.bfloat16) * 0.8)(B, Hkv, Sk, D)),
        "v": _w((lambda *s: torch.randn(*s, dtype=torch.bfloat16) * 0.05)(B, Hkv, Sk, D)),
    }

def reference(q, k, v):
    B, Hq, Sq, D = q.shape
    Hkv = k.shape[1]
    rep = Hq // Hkv
    k = (lambda x, n, axis: torch.repeat_interleave(x, n, dim=axis))(k, rep, axis=1)
    v = (lambda x, n, axis: torch.repeat_interleave(x, n, dim=axis))(v, rep, axis=1)
    scale = D ** -0.5
    scores = torch.einsum("bhqd,bhkd->bhqk", q, k) * scale
    p = _softmax(scores, axis=-1)
    return torch.einsum("bhqk,bhkd->bhqd", p, v)
```

```asm
; @launch grid=(512,1,1) block=(512,1,1) lds=151552
.amdgcn_target "amdgcn-amd-amdhsa--gfx950"
.text
.globl standalone__gqa_softmax__near_ridge_kernel
.p2align 8
.type standalone__gqa_softmax__near_ridge_kernel,@function
standalone__gqa_softmax__near_ridge_kernel:
    s_cmp_ge_u32 s2, 512
    s_cbranch_scc1 L_done
    s_load_dwordx4 s[4:7], s[0:1], 0
    s_load_dwordx4 s[8:11], s[0:1], 16
    v_lshrrev_b32 v1, 6, v0
    v_and_b32 v2, 63, v0
    v_readfirstlane_b32 s28, v1
    s_waitcnt lgkmcnt(0)
    s_mov_b32 s12, s4
    s_and_b32 s13, s5, 0xffff
    s_mov_b32 s14, 134217728
    s_mov_b32 s15, 0x00020000
    s_mov_b32 s16, s6
    s_and_b32 s17, s7, 0xffff
    s_mov_b32 s18, 33554432
    s_mov_b32 s19, 0x00020000
    s_mov_b32 s20, s8
    s_and_b32 s21, s9, 0xffff
    s_mov_b32 s22, 33554432
    s_mov_b32 s23, 0x00020000
    s_mov_b32 s24, s10
    s_and_b32 s25, s11, 0xffff
    s_mov_b32 s26, 134217728
    s_mov_b32 s27, 0x00020000
    s_mov_b32 s32, 0x3e0293ee
    v_and_b32 v3, 31, v2
    v_lshrrev_b32 v4, 5, v2
    v_and_b32 v5, 15, v2
    v_lshrrev_b32 v6, 4, v2
    v_mul_u32_u24 v192, 272, v3
    v_lshl_add_u32 v192, v4, 4, v192
    v_lshrrev_b32 v7, 2, v5
    v_lshl_add_u32 v7, v4, 2, v7
    v_mul_u32_u24 v193, 320, v7
    v_and_b32 v8, 1, v6
    v_lshl_add_u32 v193, v8, 5, v193
    v_and_b32 v8, 3, v2
    v_lshl_add_u32 v193, v8, 3, v193
    v_add_u32 v193, 69632, v193
    v_add_u32 v194, 40960, v193
    v_lshlrev_b32 v195, 8, v3
    v_lshl_add_u32 v195, v4, 4, v195
    v_lshlrev_b32 v206, 8, v6
    v_lshl_add_u32 v206, v5, 4, v206
    s_lshl_b32 s33, s28, 5
    v_add_u32 v7, s33, v6
    v_mul_u32_u24 v207, 272, v7
    v_lshl_add_u32 v207, v5, 4, v207
    v_mul_u32_u24 v208, 320, v7
    v_lshl_add_u32 v208, v5, 4, v208
    v_add_u32 v208, 69632, v208
    s_lshl_b32 s34, s2, 16
    s_lshl_b32 s35, s28, 13
    s_add_u32 s34, s34, s35
    s_add_u32 s36, s34, 4096
    s_lshl_b32 s30, s2, 18
    s_add_u32 s30, s30, s35
    buffer_load_dwordx4 v[0:3], v206, s[16:19], s34 offen offset:0
    buffer_load_dwordx4 v[4:7], v206, s[16:19], s34 offen offset:1024
    buffer_load_dwordx4 v[8:11], v206, s[16:19], s34 offen offset:2048
    buffer_load_dwordx4 v[12:15], v206, s[16:19], s34 offen offset:3072
    buffer_load_dwordx4 v[16:19], v206, s[16:19], s36 offen offset:0
    buffer_load_dwordx4 v[20:23], v206, s[16:19], s36 offen offset:1024
    buffer_load_dwordx4 v[24:27], v206, s[16:19], s36 offen offset:2048
    buffer_load_dwordx4 v[28:31], v206, s[16:19], s36 offen offset:3072
    buffer_load_dwordx4 v[32:35], v206, s[20:23], s34 offen offset:0
    buffer_load_dwordx4 v[36:39], v206, s[20:23], s34 offen offset:1024
    buffer_load_dwordx4 v[40:43], v206, s[20:23], s34 offen offset:2048
    buffer_load_dwordx4 v[44:47], v206, s[20:23], s34 offen offset:3072
    buffer_load_dwordx4 v[48:51], v206, s[20:23], s36 offen offset:0
    buffer_load_dwordx4 v[52:55], v206, s[20:23], s36 offen offset:1024
    buffer_load_dwordx4 v[56:59], v206, s[20:23], s36 offen offset:2048
    buffer_load_dwordx4 v[60:63], v206, s[20:23], s36 offen offset:3072
    buffer_load_dwordx4 v[128:131], v195, s[12:15], s30 offen offset:0
    buffer_load_dwordx4 v[132:135], v195, s[12:15], s30 offen offset:32
    buffer_load_dwordx4 v[136:139], v195, s[12:15], s30 offen offset:64
    buffer_load_dwordx4 v[140:143], v195, s[12:15], s30 offen offset:96
    buffer_load_dwordx4 v[144:147], v195, s[12:15], s30 offen offset:128
    buffer_load_dwordx4 v[148:151], v195, s[12:15], s30 offen offset:160
    buffer_load_dwordx4 v[152:155], v195, s[12:15], s30 offen offset:192
    buffer_load_dwordx4 v[156:159], v195, s[12:15], s30 offen offset:224
    s_waitcnt vmcnt(16)
    ds_write_b128 v207, v[0:3] offset:0
    ds_write_b128 v207, v[4:7] offset:1088
    ds_write_b128 v207, v[8:11] offset:2176
    ds_write_b128 v207, v[12:15] offset:3264
    ds_write_b128 v207, v[16:19] offset:4352
    ds_write_b128 v207, v[20:23] offset:5440
    ds_write_b128 v207, v[24:27] offset:6528
    ds_write_b128 v207, v[28:31] offset:7616
    s_waitcnt vmcnt(8)
    ds_write_b128 v208, v[32:35] offset:0
    ds_write_b128 v208, v[36:39] offset:1280
    ds_write_b128 v208, v[40:43] offset:2560
    ds_write_b128 v208, v[44:47] offset:3840
    ds_write_b128 v208, v[48:51] offset:5120
    ds_write_b128 v208, v[52:55] offset:6400
    ds_write_b128 v208, v[56:59] offset:7680
    ds_write_b128 v208, v[60:63] offset:8960
    s_waitcnt lgkmcnt(0)
    s_barrier
    s_mov_b32 s29, 0
    s_waitcnt vmcnt(0)
L_loop:
    ds_read_b128 v[160:163], v192 offset:0
    ds_read_b128 v[164:167], v192 offset:32
    ds_read_b128 v[168:171], v192 offset:64
    ds_read_b128 v[172:175], v192 offset:96
    ds_read_b128 v[176:179], v192 offset:128
    s_waitcnt lgkmcnt(4)
    v_mfma_f32_32x32x16_bf16 v[0:15], v[160:163], v[128:131], 0
    ds_read_b128 v[180:183], v192 offset:160
    s_waitcnt lgkmcnt(4)
    v_mfma_f32_32x32x16_bf16 v[0:15], v[164:167], v[132:135], v[0:15]
    ds_read_b128 v[184:187], v192 offset:192
    s_waitcnt lgkmcnt(4)
    v_mfma_f32_32x32x16_bf16 v[0:15], v[168:171], v[136:139], v[0:15]
    ds_read_b128 v[188:191], v192 offset:224
    s_waitcnt lgkmcnt(4)
    v_mfma_f32_32x32x16_bf16 v[0:15], v[172:175], v[140:143], v[0:15]
    ds_read_b128 v[160:163], v192 offset:8704
    s_waitcnt lgkmcnt(4)
    v_mfma_f32_32x32x16_bf16 v[0:15], v[176:179], v[144:147], v[0:15]
    ds_read_b128 v[164:167], v192 offset:8736
    s_waitcnt lgkmcnt(4)
    v_mfma_f32_32x32x16_bf16 v[0:15], v[180:183], v[148:151], v[0:15]
    ds_read_b128 v[168:171], v192 offset:8768
    s_waitcnt lgkmcnt(4)
    v_mfma_f32_32x32x16_bf16 v[0:15], v[184:187], v[152:155], v[0:15]
    ds_read_b128 v[172:175], v192 offset:8800
    s_waitcnt lgkmcnt(4)
    v_mfma_f32_32x32x16_bf16 v[0:15], v[188:191], v[156:159], v[0:15]
    ds_read_b128 v[176:179], v192 offset:8832
    s_waitcnt lgkmcnt(4)
    v_mfma_f32_32x32x16_bf16 v[16:31], v[160:163], v[128:131], 0
    ds_read_b128 v[180:183], v192 offset:8864
    s_waitcnt lgkmcnt(4)
    v_mfma_f32_32x32x16_bf16 v[16:31], v[164:167], v[132:135], v[16:31]
    ds_read_b128 v[184:187], v192 offset:8896
    s_waitcnt lgkmcnt(4)
    v_mfma_f32_32x32x16_bf16 v[16:31], v[168:171], v[136:139], v[16:31]
    ds_read_b128 v[188:191], v192 offset:8928
    s_waitcnt lgkmcnt(4)
    v_mfma_f32_32x32x16_bf16 v[16:31], v[172:175], v[140:143], v[16:31]
    ds_read_b128 v[160:163], v192 offset:17408
    s_waitcnt lgkmcnt(4)
    v_mfma_f32_32x32x16_bf16 v[16:31], v[176:179], v[144:147], v[16:31]
    ds_read_b128 v[164:167], v192 offset:17440
    s_waitcnt lgkmcnt(4)
    v_mfma_f32_32x32x16_bf16 v[16:31], v[180:183], v[148:151], v[16:31]
    ds_read_b128 v[168:171], v192 offset:17472
    s_waitcnt lgkmcnt(4)
    v_mfma_f32_32x32x16_bf16 v[16:31], v[184:187], v[152:155], v[16:31]
    ds_read_b128 v[172:175], v192 offset:17504
    s_waitcnt lgkmcnt(4)
    v_mfma_f32_32x32x16_bf16 v[16:31], v[188:191], v[156:159], v[16:31]
    ds_read_b128 v[176:179], v192 offset:17536
    s_waitcnt lgkmcnt(4)
    v_mfma_f32_32x32x16_bf16 v[32:47], v[160:163], v[128:131], 0
    ds_read_b128 v[180:183], v192 offset:17568
    s_waitcnt lgkmcnt(4)
    v_mfma_f32_32x32x16_bf16 v[32:47], v[164:167], v[132:135], v[32:47]
    ds_read_b128 v[184:187], v192 offset:17600
    s_waitcnt lgkmcnt(4)
    v_mfma_f32_32x32x16_bf16 v[32:47], v[168:171], v[136:139], v[32:47]
    ds_read_b128 v[188:191], v192 offset:17632
    s_waitcnt lgkmcnt(4)
    v_mfma_f32_32x32x16_bf16 v[32:47], v[172:175], v[140:143], v[32:47]
    ds_read_b128 v[160:163], v192 offset:26112
    s_waitcnt lgkmcnt(4)
    v_mfma_f32_32x32x16_bf16 v[32:47], v[176:179], v[144:147], v[32:47]
    ds_read_b128 v[164:167], v192 offset:26144
    s_waitcnt lgkmcnt(4)
    v_mfma_f32_32x32x16_bf16 v[32:47], v[180:183], v[148:151], v[32:47]
    ds_read_b128 v[168:171], v192 offset:26176
    s_waitcnt lgkmcnt(4)
    v_mfma_f32_32x32x16_bf16 v[32:47], v[184:187], v[152:155], v[32:47]
    ds_read_b128 v[172:175], v192 offset:26208
    s_waitcnt lgkmcnt(4)
    v_mfma_f32_32x32x16_bf16 v[32:47], v[188:191], v[156:159], v[32:47]
    ds_read_b128 v[176:179], v192 offset:26240
    s_waitcnt lgkmcnt(4)
    v_mfma_f32_32x32x16_bf16 v[48:63], v[160:163], v[128:131], 0
    ds_read_b128 v[180:183], v192 offset:26272
    s_waitcnt lgkmcnt(4)
    v_mfma_f32_32x32x16_bf16 v[48:63], v[164:167], v[132:135], v[48:63]
    ds_read_b128 v[184:187], v192 offset:26304
    s_waitcnt lgkmcnt(4)
    v_mfma_f32_32x32x16_bf16 v[48:63], v[168:171], v[136:139], v[48:63]
    ds_read_b128 v[188:191], v192 offset:26336
    s_waitcnt lgkmcnt(4)
    v_mfma_f32_32x32x16_bf16 v[48:63], v[172:175], v[140:143], v[48:63]
    ds_read_b128 v[160:163], v192 offset:34816
    s_waitcnt lgkmcnt(4)
    v_mfma_f32_32x32x16_bf16 v[48:63], v[176:179], v[144:147], v[48:63]
    ds_read_b128 v[164:167], v192 offset:34848
    s_waitcnt lgkmcnt(4)
    v_mfma_f32_32x32x16_bf16 v[48:63], v[180:183], v[148:151], v[48:63]
    ds_read_b128 v[168:171], v192 offset:34880
    s_waitcnt lgkmcnt(4)
    v_mfma_f32_32x32x16_bf16 v[48:63], v[184:187], v[152:155], v[48:63]
    ds_read_b128 v[172:175], v192 offset:34912
    s_waitcnt lgkmcnt(4)
    v_mfma_f32_32x32x16_bf16 v[48:63], v[188:191], v[156:159], v[48:63]
    ds_read_b128 v[176:179], v192 offset:34944
    s_waitcnt lgkmcnt(4)
    v_mfma_f32_32x32x16_bf16 v[64:79], v[160:163], v[128:131], 0
    ds_read_b128 v[180:183], v192 offset:34976
    s_waitcnt lgkmcnt(4)
    v_mfma_f32_32x32x16_bf16 v[64:79], v[164:167], v[132:135], v[64:79]
    ds_read_b128 v[184:187], v192 offset:35008
    s_waitcnt lgkmcnt(4)
    v_mfma_f32_32x32x16_bf16 v[64:79], v[168:171], v[136:139], v[64:79]
    ds_read_b128 v[188:191], v192 offset:35040
    s_waitcnt lgkmcnt(4)
    v_mfma_f32_32x32x16_bf16 v[64:79], v[172:175], v[140:143], v[64:79]
    ds_read_b128 v[160:163], v192 offset:43520
    s_waitcnt lgkmcnt(4)
    v_mfma_f32_32x32x16_bf16 v[64:79], v[176:179], v[144:147], v[64:79]
    ds_read_b128 v[164:167], v192 offset:43552
    s_waitcnt lgkmcnt(4)
    v_mfma_f32_32x32x16_bf16 v[64:79], v[180:183], v[148:151], v[64:79]
    ds_read_b128 v[168:171], v192 offset:43584
    s_waitcnt lgkmcnt(4)
    v_mfma_f32_32x32x16_bf16 v[64:79], v[184:187], v[152:155], v[64:79]
    ds_read_b128 v[172:175], v192 offset:43616
    s_waitcnt lgkmcnt(4)
    v_mfma_f32_32x32x16_bf16 v[64:79], v[188:191], v[156:159], v[64:79]
    ds_read_b128 v[176:179], v192 offset:43648
    s_waitcnt lgkmcnt(4)
    v_mfma_f32_32x32x16_bf16 v[80:95], v[160:163], v[128:131], 0
    ds_read_b128 v[180:183], v192 offset:43680
    s_waitcnt lgkmcnt(4)
    v_mfma_f32_32x32x16_bf16 v[80:95], v[164:167], v[132:135], v[80:95]
    ds_read_b128 v[184:187], v192 offset:43712
    s_waitcnt lgkmcnt(4)
    v_mfma_f32_32x32x16_bf16 v[80:95], v[168:171], v[136:139], v[80:95]
    ds_read_b128 v[188:191], v192 offset:43744
    s_waitcnt lgkmcnt(4)
    v_mfma_f32_32x32x16_bf16 v[80:95], v[172:175], v[140:143], v[80:95]
    ds_read_b128 v[160:163], v192 offset:52224
    s_waitcnt lgkmcnt(4)
    v_mfma_f32_32x32x16_bf16 v[80:95], v[176:179], v[144:147], v[80:95]
    ds_read_b128 v[164:167], v192 offset:52256
    s_waitcnt lgkmcnt(4)
    v_mfma_f32_32x32x16_bf16 v[80:95], v[180:183], v[148:151], v[80:95]
    ds_read_b128 v[168:171], v192 offset:52288
    s_waitcnt lgkmcnt(4)
    v_mfma_f32_32x32x16_bf16 v[80:95], v[184:187], v[152:155], v[80:95]
    ds_read_b128 v[172:175], v192 offset:52320
    s_waitcnt lgkmcnt(4)
    v_mfma_f32_32x32x16_bf16 v[80:95], v[188:191], v[156:159], v[80:95]
    ds_read_b128 v[176:179], v192 offset:52352
    s_waitcnt lgkmcnt(4)
    v_mfma_f32_32x32x16_bf16 v[96:111], v[160:163], v[128:131], 0
    ds_read_b128 v[180:183], v192 offset:52384
    s_waitcnt lgkmcnt(4)
    v_mfma_f32_32x32x16_bf16 v[96:111], v[164:167], v[132:135], v[96:111]
    ds_read_b128 v[184:187], v192 offset:52416
    s_waitcnt lgkmcnt(4)
    v_mfma_f32_32x32x16_bf16 v[96:111], v[168:171], v[136:139], v[96:111]
    ds_read_b128 v[188:191], v192 offset:52448
    s_waitcnt lgkmcnt(4)
    v_mfma_f32_32x32x16_bf16 v[96:111], v[172:175], v[140:143], v[96:111]
    ds_read_b128 v[160:163], v192 offset:60928
    s_waitcnt lgkmcnt(4)
    v_mfma_f32_32x32x16_bf16 v[96:111], v[176:179], v[144:147], v[96:111]
    ds_read_b128 v[164:167], v192 offset:60960
    s_waitcnt lgkmcnt(4)
    v_mfma_f32_32x32x16_bf16 v[96:111], v[180:183], v[148:151], v[96:111]
    ds_read_b128 v[168:171], v192 offset:60992
    s_waitcnt lgkmcnt(4)
    v_mfma_f32_32x32x16_bf16 v[96:111], v[184:187], v[152:155], v[96:111]
    ds_read_b128 v[172:175], v192 offset:61024
    s_waitcnt lgkmcnt(4)
    v_mfma_f32_32x32x16_bf16 v[96:111], v[188:191], v[156:159], v[96:111]
    ds_read_b128 v[176:179], v192 offset:61056
    s_waitcnt lgkmcnt(4)
    v_mfma_f32_32x32x16_bf16 v[112:127], v[160:163], v[128:131], 0
    ds_read_b128 v[180:183], v192 offset:61088
    s_waitcnt lgkmcnt(4)
    v_mfma_f32_32x32x16_bf16 v[112:127], v[164:167], v[132:135], v[112:127]
    ds_read_b128 v[184:187], v192 offset:61120
    s_waitcnt lgkmcnt(4)
    v_mfma_f32_32x32x16_bf16 v[112:127], v[168:171], v[136:139], v[112:127]
    ds_read_b128 v[188:191], v192 offset:61152
    s_waitcnt lgkmcnt(4)
    v_mfma_f32_32x32x16_bf16 v[112:127], v[172:175], v[140:143], v[112:127]
    s_waitcnt lgkmcnt(3)
    v_mfma_f32_32x32x16_bf16 v[112:127], v[176:179], v[144:147], v[112:127]
    s_waitcnt lgkmcnt(2)
    v_mfma_f32_32x32x16_bf16 v[112:127], v[180:183], v[148:151], v[112:127]
    s_waitcnt lgkmcnt(1)
    v_mfma_f32_32x32x16_bf16 v[112:127], v[184:187], v[152:155], v[112:127]
    s_waitcnt lgkmcnt(0)
    v_mfma_f32_32x32x16_bf16 v[112:127], v[188:191], v[156:159], v[112:127]
    s_add_u32 s31, s30, 0
    s_add_u32 s30, s30, 65536
    s_cmp_lt_u32 s29, 3
    s_cbranch_scc0 L_noq
    buffer_load_dwordx4 v[128:131], v195, s[12:15], s30 offen offset:0
    buffer_load_dwordx4 v[132:135], v195, s[12:15], s30 offen offset:32
    buffer_load_dwordx4 v[136:139], v195, s[12:15], s30 offen offset:64
    buffer_load_dwordx4 v[140:143], v195, s[12:15], s30 offen offset:96
    buffer_load_dwordx4 v[144:147], v195, s[12:15], s30 offen offset:128
    buffer_load_dwordx4 v[148:151], v195, s[12:15], s30 offen offset:160
    buffer_load_dwordx4 v[152:155], v195, s[12:15], s30 offen offset:192
    buffer_load_dwordx4 v[156:159], v195, s[12:15], s30 offen offset:224
L_noq:
    v_max3_f32 v197, v0, v1, v2
    v_max3_f32 v197, v197, v3, v4
    v_max3_f32 v197, v197, v5, v6
    v_max3_f32 v197, v197, v7, v8
    v_max3_f32 v197, v197, v9, v10
    v_max3_f32 v197, v197, v11, v12
    v_max3_f32 v197, v197, v13, v14
    v_max3_f32 v197, v197, v15, v16
    v_max3_f32 v197, v197, v17, v18
    v_max3_f32 v197, v197, v19, v20
    v_max3_f32 v197, v197, v21, v22
    v_max3_f32 v197, v197, v23, v24
    v_max3_f32 v197, v197, v25, v26
    v_max3_f32 v197, v197, v27, v28
    v_max3_f32 v197, v197, v29, v30
    v_max3_f32 v197, v197, v31, v32
    v_max3_f32 v197, v197, v33, v34
    v_max3_f32 v197, v197, v35, v36
    v_max3_f32 v197, v197, v37, v38
    v_max3_f32 v197, v197, v39, v40
    v_max3_f32 v197, v197, v41, v42
    v_max3_f32 v197, v197, v43, v44
    v_max3_f32 v197, v197, v45, v46
    v_max3_f32 v197, v197, v47, v48
    v_max3_f32 v197, v197, v49, v50
    v_max3_f32 v197, v197, v51, v52
    v_max3_f32 v197, v197, v53, v54
    v_max3_f32 v197, v197, v55, v56
    v_max3_f32 v197, v197, v57, v58
    v_max3_f32 v197, v197, v59, v60
    v_max3_f32 v197, v197, v61, v62
    v_max3_f32 v197, v197, v63, v64
    v_max3_f32 v197, v197, v65, v66
    v_max3_f32 v197, v197, v67, v68
    v_max3_f32 v197, v197, v69, v70
    v_max3_f32 v197, v197, v71, v72
    v_max3_f32 v197, v197, v73, v74
    v_max3_f32 v197, v197, v75, v76
    v_max3_f32 v197, v197, v77, v78
    v_max3_f32 v197, v197, v79, v80
    v_max3_f32 v197, v197, v81, v82
    v_max3_f32 v197, v197, v83, v84
    v_max3_f32 v197, v197, v85, v86
    v_max3_f32 v197, v197, v87, v88
    v_max3_f32 v197, v197, v89, v90
    v_max3_f32 v197, v197, v91, v92
    v_max3_f32 v197, v197, v93, v94
    v_max3_f32 v197, v197, v95, v96
    v_max3_f32 v197, v197, v97, v98
    v_max3_f32 v197, v197, v99, v100
    v_max3_f32 v197, v197, v101, v102
    v_max3_f32 v197, v197, v103, v104
    v_max3_f32 v197, v197, v105, v106
    v_max3_f32 v197, v197, v107, v108
    v_max3_f32 v197, v197, v109, v110
    v_max3_f32 v197, v197, v111, v112
    v_max3_f32 v197, v197, v113, v114
    v_max3_f32 v197, v197, v115, v116
    v_max3_f32 v197, v197, v117, v118
    v_max3_f32 v197, v197, v119, v120
    v_max3_f32 v197, v197, v121, v122
    v_max3_f32 v197, v197, v123, v124
    v_max3_f32 v197, v197, v125, v126
    v_max_f32 v197, v197, v127
    v_mov_b32 v198, v197
    s_nop 1
    v_permlane32_swap_b32 v197, v198
    v_max_f32 v197, v197, v198
    v_mul_f32 v199, s32, v197
    v_mov_b32 v200, 0
    v_mov_b32 v201, 0
    v_mov_b32 v202, 0
    v_mov_b32 v203, 0
    v_fma_f32 v0, v0, s32, -v199
    v_fma_f32 v1, v1, s32, -v199
    v_fma_f32 v2, v2, s32, -v199
    v_fma_f32 v3, v3, s32, -v199
    v_exp_f32 v0, v0
    v_exp_f32 v1, v1
    v_exp_f32 v2, v2
    v_exp_f32 v3, v3
    v_add_f32 v200, v200, v0
    v_add_f32 v201, v201, v1
    v_add_f32 v202, v202, v2
    v_add_f32 v203, v203, v3
    v_cvt_pk_bf16_f32 v0, v0, v1
    v_cvt_pk_bf16_f32 v1, v2, v3
    v_fma_f32 v4, v4, s32, -v199
    v_fma_f32 v5, v5, s32, -v199
    v_fma_f32 v6, v6, s32, -v199
    v_fma_f32 v7, v7, s32, -v199
    v_exp_f32 v4, v4
    v_exp_f32 v5, v5
    v_exp_f32 v6, v6
    v_exp_f32 v7, v7
    v_add_f32 v200, v200, v4
    v_add_f32 v201, v201, v5
    v_add_f32 v202, v202, v6
    v_add_f32 v203, v203, v7
    v_cvt_pk_bf16_f32 v2, v4, v5
    v_cvt_pk_bf16_f32 v3, v6, v7
    v_fma_f32 v8, v8, s32, -v199
    v_fma_f32 v9, v9, s32, -v199
    v_fma_f32 v10, v10, s32, -v199
    v_fma_f32 v11, v11, s32, -v199
    v_exp_f32 v8, v8
    v_exp_f32 v9, v9
    v_exp_f32 v10, v10
    v_exp_f32 v11, v11
    v_add_f32 v200, v200, v8
    v_add_f32 v201, v201, v9
    v_add_f32 v202, v202, v10
    v_add_f32 v203, v203, v11
    v_cvt_pk_bf16_f32 v4, v8, v9
    v_cvt_pk_bf16_f32 v5, v10, v11
    v_fma_f32 v12, v12, s32, -v199
    v_fma_f32 v13, v13, s32, -v199
    v_fma_f32 v14, v14, s32, -v199
    v_fma_f32 v15, v15, s32, -v199
    v_exp_f32 v12, v12
    v_exp_f32 v13, v13
    v_exp_f32 v14, v14
    v_exp_f32 v15, v15
    v_add_f32 v200, v200, v12
    v_add_f32 v201, v201, v13
    v_add_f32 v202, v202, v14
    v_add_f32 v203, v203, v15
    v_cvt_pk_bf16_f32 v6, v12, v13
    v_cvt_pk_bf16_f32 v7, v14, v15
    v_fma_f32 v16, v16, s32, -v199
    v_fma_f32 v17, v17, s32, -v199
    v_fma_f32 v18, v18, s32, -v199
    v_fma_f32 v19, v19, s32, -v199
    v_exp_f32 v16, v16
    v_exp_f32 v17, v17
    v_exp_f32 v18, v18
    v_exp_f32 v19, v19
    v_add_f32 v200, v200, v16
    v_add_f32 v201, v201, v17
    v_add_f32 v202, v202, v18
    v_add_f32 v203, v203, v19
    v_cvt_pk_bf16_f32 v8, v16, v17
    v_cvt_pk_bf16_f32 v9, v18, v19
    v_fma_f32 v20, v20, s32, -v199
    v_fma_f32 v21, v21, s32, -v199
    v_fma_f32 v22, v22, s32, -v199
    v_fma_f32 v23, v23, s32, -v199
    v_exp_f32 v20, v20
    v_exp_f32 v21, v21
    v_exp_f32 v22, v22
    v_exp_f32 v23, v23
    v_add_f32 v200, v200, v20
    v_add_f32 v201, v201, v21
    v_add_f32 v202, v202, v22
    v_add_f32 v203, v203, v23
    v_cvt_pk_bf16_f32 v10, v20, v21
    v_cvt_pk_bf16_f32 v11, v22, v23
    v_fma_f32 v24, v24, s32, -v199
    v_fma_f32 v25, v25, s32, -v199
    v_fma_f32 v26, v26, s32, -v199
    v_fma_f32 v27, v27, s32, -v199
    v_exp_f32 v24, v24
    v_exp_f32 v25, v25
    v_exp_f32 v26, v26
    v_exp_f32 v27, v27
    v_add_f32 v200, v200, v24
    v_add_f32 v201, v201, v25
    v_add_f32 v202, v202, v26
    v_add_f32 v203, v203, v27
    v_cvt_pk_bf16_f32 v12, v24, v25
    v_cvt_pk_bf16_f32 v13, v26, v27
    v_fma_f32 v28, v28, s32, -v199
    v_fma_f32 v29, v29, s32, -v199
    v_fma_f32 v30, v30, s32, -v199
    v_fma_f32 v31, v31, s32, -v199
    v_exp_f32 v28, v28
    v_exp_f32 v29, v29
    v_exp_f32 v30, v30
    v_exp_f32 v31, v31
    v_add_f32 v200, v200, v28
    v_add_f32 v201, v201, v29
    v_add_f32 v202, v202, v30
    v_add_f32 v203, v203, v31
    v_cvt_pk_bf16_f32 v14, v28, v29
    v_cvt_pk_bf16_f32 v15, v30, v31
    v_fma_f32 v32, v32, s32, -v199
    v_fma_f32 v33, v33, s32, -v199
    v_fma_f32 v34, v34, s32, -v199
    v_fma_f32 v35, v35, s32, -v199
    v_exp_f32 v32, v32
    v_exp_f32 v33, v33
    v_exp_f32 v34, v34
    v_exp_f32 v35, v35
    v_add_f32 v200, v200, v32
    v_add_f32 v201, v201, v33
    v_add_f32 v202, v202, v34
    v_add_f32 v203, v203, v35
    v_cvt_pk_bf16_f32 v16, v32, v33
    v_cvt_pk_bf16_f32 v17, v34, v35
    v_fma_f32 v36, v36, s32, -v199
    v_fma_f32 v37, v37, s32, -v199
    v_fma_f32 v38, v38, s32, -v199
    v_fma_f32 v39, v39, s32, -v199
    v_exp_f32 v36, v36
    v_exp_f32 v37, v37
    v_exp_f32 v38, v38
    v_exp_f32 v39, v39
    v_add_f32 v200, v200, v36
    v_add_f32 v201, v201, v37
    v_add_f32 v202, v202, v38
    v_add_f32 v203, v203, v39
    v_cvt_pk_bf16_f32 v18, v36, v37
    v_cvt_pk_bf16_f32 v19, v38, v39
    v_fma_f32 v40, v40, s32, -v199
    v_fma_f32 v41, v41, s32, -v199
    v_fma_f32 v42, v42, s32, -v199
    v_fma_f32 v43, v43, s32, -v199
    v_exp_f32 v40, v40
    v_exp_f32 v41, v41
    v_exp_f32 v42, v42
    v_exp_f32 v43, v43
    v_add_f32 v200, v200, v40
    v_add_f32 v201, v201, v41
    v_add_f32 v202, v202, v42
    v_add_f32 v203, v203, v43
    v_cvt_pk_bf16_f32 v20, v40, v41
    v_cvt_pk_bf16_f32 v21, v42, v43
    v_fma_f32 v44, v44, s32, -v199
    v_fma_f32 v45, v45, s32, -v199
    v_fma_f32 v46, v46, s32, -v199
    v_fma_f32 v47, v47, s32, -v199
    v_exp_f32 v44, v44
    v_exp_f32 v45, v45
    v_exp_f32 v46, v46
    v_exp_f32 v47, v47
    v_add_f32 v200, v200, v44
    v_add_f32 v201, v201, v45
    v_add_f32 v202, v202, v46
    v_add_f32 v203, v203, v47
    v_cvt_pk_bf16_f32 v22, v44, v45
    v_cvt_pk_bf16_f32 v23, v46, v47
    v_fma_f32 v48, v48, s32, -v199
    v_fma_f32 v49, v49, s32, -v199
    v_fma_f32 v50, v50, s32, -v199
    v_fma_f32 v51, v51, s32, -v199
    v_exp_f32 v48, v48
    v_exp_f32 v49, v49
    v_exp_f32 v50, v50
    v_exp_f32 v51, v51
    v_add_f32 v200, v200, v48
    v_add_f32 v201, v201, v49
    v_add_f32 v202, v202, v50
    v_add_f32 v203, v203, v51
    v_cvt_pk_bf16_f32 v24, v48, v49
    v_cvt_pk_bf16_f32 v25, v50, v51
    v_fma_f32 v52, v52, s32, -v199
    v_fma_f32 v53, v53, s32, -v199
    v_fma_f32 v54, v54, s32, -v199
    v_fma_f32 v55, v55, s32, -v199
    v_exp_f32 v52, v52
    v_exp_f32 v53, v53
    v_exp_f32 v54, v54
    v_exp_f32 v55, v55
    v_add_f32 v200, v200, v52
    v_add_f32 v201, v201, v53
    v_add_f32 v202, v202, v54
    v_add_f32 v203, v203, v55
    v_cvt_pk_bf16_f32 v26, v52, v53
    v_cvt_pk_bf16_f32 v27, v54, v55
    v_fma_f32 v56, v56, s32, -v199
    v_fma_f32 v57, v57, s32, -v199
    v_fma_f32 v58, v58, s32, -v199
    v_fma_f32 v59, v59, s32, -v199
    v_exp_f32 v56, v56
    v_exp_f32 v57, v57
    v_exp_f32 v58, v58
    v_exp_f32 v59, v59
    v_add_f32 v200, v200, v56
    v_add_f32 v201, v201, v57
    v_add_f32 v202, v202, v58
    v_add_f32 v203, v203, v59
    v_cvt_pk_bf16_f32 v28, v56, v57
    v_cvt_pk_bf16_f32 v29, v58, v59
    v_fma_f32 v60, v60, s32, -v199
    v_fma_f32 v61, v61, s32, -v199
    v_fma_f32 v62, v62, s32, -v199
    v_fma_f32 v63, v63, s32, -v199
    v_exp_f32 v60, v60
    v_exp_f32 v61, v61
    v_exp_f32 v62, v62
    v_exp_f32 v63, v63
    v_add_f32 v200, v200, v60
    v_add_f32 v201, v201, v61
    v_add_f32 v202, v202, v62
    v_add_f32 v203, v203, v63
    v_cvt_pk_bf16_f32 v30, v60, v61
    v_cvt_pk_bf16_f32 v31, v62, v63
    v_fma_f32 v64, v64, s32, -v199
    v_fma_f32 v65, v65, s32, -v199
    v_fma_f32 v66, v66, s32, -v199
    v_fma_f32 v67, v67, s32, -v199
    v_exp_f32 v64, v64
    v_exp_f32 v65, v65
    v_exp_f32 v66, v66
    v_exp_f32 v67, v67
    v_add_f32 v200, v200, v64
    v_add_f32 v201, v201, v65
    v_add_f32 v202, v202, v66
    v_add_f32 v203, v203, v67
    v_cvt_pk_bf16_f32 v32, v64, v65
    v_cvt_pk_bf16_f32 v33, v66, v67
    v_fma_f32 v68, v68, s32, -v199
    v_fma_f32 v69, v69, s32, -v199
    v_fma_f32 v70, v70, s32, -v199
    v_fma_f32 v71, v71, s32, -v199
    v_exp_f32 v68, v68
    v_exp_f32 v69, v69
    v_exp_f32 v70, v70
    v_exp_f32 v71, v71
    v_add_f32 v200, v200, v68
    v_add_f32 v201, v201, v69
    v_add_f32 v202, v202, v70
    v_add_f32 v203, v203, v71
    v_cvt_pk_bf16_f32 v34, v68, v69
    v_cvt_pk_bf16_f32 v35, v70, v71
    v_fma_f32 v72, v72, s32, -v199
    v_fma_f32 v73, v73, s32, -v199
    v_fma_f32 v74, v74, s32, -v199
    v_fma_f32 v75, v75, s32, -v199
    v_exp_f32 v72, v72
    v_exp_f32 v73, v73
    v_exp_f32 v74, v74
    v_exp_f32 v75, v75
    v_add_f32 v200, v200, v72
    v_add_f32 v201, v201, v73
    v_add_f32 v202, v202, v74
    v_add_f32 v203, v203, v75
    v_cvt_pk_bf16_f32 v36, v72, v73
    v_cvt_pk_bf16_f32 v37, v74, v75
    v_fma_f32 v76, v76, s32, -v199
    v_fma_f32 v77, v77, s32, -v199
    v_fma_f32 v78, v78, s32, -v199
    v_fma_f32 v79, v79, s32, -v199
    v_exp_f32 v76, v76
    v_exp_f32 v77, v77
    v_exp_f32 v78, v78
    v_exp_f32 v79, v79
    v_add_f32 v200, v200, v76
    v_add_f32 v201, v201, v77
    v_add_f32 v202, v202, v78
    v_add_f32 v203, v203, v79
    v_cvt_pk_bf16_f32 v38, v76, v77
    v_cvt_pk_bf16_f32 v39, v78, v79
    v_fma_f32 v80, v80, s32, -v199
    v_fma_f32 v81, v81, s32, -v199
    v_fma_f32 v82, v82, s32, -v199
    v_fma_f32 v83, v83, s32, -v199
    v_exp_f32 v80, v80
    v_exp_f32 v81, v81
    v_exp_f32 v82, v82
    v_exp_f32 v83, v83
    v_add_f32 v200, v200, v80
    v_add_f32 v201, v201, v81
    v_add_f32 v202, v202, v82
    v_add_f32 v203, v203, v83
    v_cvt_pk_bf16_f32 v40, v80, v81
    v_cvt_pk_bf16_f32 v41, v82, v83
    v_fma_f32 v84, v84, s32, -v199
    v_fma_f32 v85, v85, s32, -v199
    v_fma_f32 v86, v86, s32, -v199
    v_fma_f32 v87, v87, s32, -v199
    v_exp_f32 v84, v84
    v_exp_f32 v85, v85
    v_exp_f32 v86, v86
    v_exp_f32 v87, v87
    v_add_f32 v200, v200, v84
    v_add_f32 v201, v201, v85
    v_add_f32 v202, v202, v86
    v_add_f32 v203, v203, v87
    v_cvt_pk_bf16_f32 v42, v84, v85
    v_cvt_pk_bf16_f32 v43, v86, v87
    v_fma_f32 v88, v88, s32, -v199
    v_fma_f32 v89, v89, s32, -v199
    v_fma_f32 v90, v90, s32, -v199
    v_fma_f32 v91, v91, s32, -v199
    v_exp_f32 v88, v88
    v_exp_f32 v89, v89
    v_exp_f32 v90, v90
    v_exp_f32 v91, v91
    v_add_f32 v200, v200, v88
    v_add_f32 v201, v201, v89
    v_add_f32 v202, v202, v90
    v_add_f32 v203, v203, v91
    v_cvt_pk_bf16_f32 v44, v88, v89
    v_cvt_pk_bf16_f32 v45, v90, v91
    v_fma_f32 v92, v92, s32, -v199
    v_fma_f32 v93, v93, s32, -v199
    v_fma_f32 v94, v94, s32, -v199
    v_fma_f32 v95, v95, s32, -v199
    v_exp_f32 v92, v92
    v_exp_f32 v93, v93
    v_exp_f32 v94, v94
    v_exp_f32 v95, v95
    v_add_f32 v200, v200, v92
    v_add_f32 v201, v201, v93
    v_add_f32 v202, v202, v94
    v_add_f32 v203, v203, v95
    v_cvt_pk_bf16_f32 v46, v92, v93
    v_cvt_pk_bf16_f32 v47, v94, v95
    v_fma_f32 v96, v96, s32, -v199
    v_fma_f32 v97, v97, s32, -v199
    v_fma_f32 v98, v98, s32, -v199
    v_fma_f32 v99, v99, s32, -v199
    v_exp_f32 v96, v96
    v_exp_f32 v97, v97
    v_exp_f32 v98, v98
    v_exp_f32 v99, v99
    v_add_f32 v200, v200, v96
    v_add_f32 v201, v201, v97
    v_add_f32 v202, v202, v98
    v_add_f32 v203, v203, v99
    v_cvt_pk_bf16_f32 v48, v96, v97
    v_cvt_pk_bf16_f32 v49, v98, v99
    v_fma_f32 v100, v100, s32, -v199
    v_fma_f32 v101, v101, s32, -v199
    v_fma_f32 v102, v102, s32, -v199
    v_fma_f32 v103, v103, s32, -v199
    v_exp_f32 v100, v100
    v_exp_f32 v101, v101
    v_exp_f32 v102, v102
    v_exp_f32 v103, v103
    v_add_f32 v200, v200, v100
    v_add_f32 v201, v201, v101
    v_add_f32 v202, v202, v102
    v_add_f32 v203, v203, v103
    v_cvt_pk_bf16_f32 v50, v100, v101
    v_cvt_pk_bf16_f32 v51, v102, v103
    v_fma_f32 v104, v104, s32, -v199
    v_fma_f32 v105, v105, s32, -v199
    v_fma_f32 v106, v106, s32, -v199
    v_fma_f32 v107, v107, s32, -v199
    v_exp_f32 v104, v104
    v_exp_f32 v105, v105
    v_exp_f32 v106, v106
    v_exp_f32 v107, v107
    v_add_f32 v200, v200, v104
    v_add_f32 v201, v201, v105
    v_add_f32 v202, v202, v106
    v_add_f32 v203, v203, v107
    v_cvt_pk_bf16_f32 v52, v104, v105
    v_cvt_pk_bf16_f32 v53, v106, v107
    v_fma_f32 v108, v108, s32, -v199
    v_fma_f32 v109, v109, s32, -v199
    v_fma_f32 v110, v110, s32, -v199
    v_fma_f32 v111, v111, s32, -v199
    v_exp_f32 v108, v108
    v_exp_f32 v109, v109
    v_exp_f32 v110, v110
    v_exp_f32 v111, v111
    v_add_f32 v200, v200, v108
    v_add_f32 v201, v201, v109
    v_add_f32 v202, v202, v110
    v_add_f32 v203, v203, v111
    v_cvt_pk_bf16_f32 v54, v108, v109
    v_cvt_pk_bf16_f32 v55, v110, v111
    v_fma_f32 v112, v112, s32, -v199
    v_fma_f32 v113, v113, s32, -v199
    v_fma_f32 v114, v114, s32, -v199
    v_fma_f32 v115, v115, s32, -v199
    v_exp_f32 v112, v112
    v_exp_f32 v113, v113
    v_exp_f32 v114, v114
    v_exp_f32 v115, v115
    v_add_f32 v200, v200, v112
    v_add_f32 v201, v201, v113
    v_add_f32 v202, v202, v114
    v_add_f32 v203, v203, v115
    v_cvt_pk_bf16_f32 v56, v112, v113
    v_cvt_pk_bf16_f32 v57, v114, v115
    v_fma_f32 v116, v116, s32, -v199
    v_fma_f32 v117, v117, s32, -v199
    v_fma_f32 v118, v118, s32, -v199
    v_fma_f32 v119, v119, s32, -v199
    v_exp_f32 v116, v116
    v_exp_f32 v117, v117
    v_exp_f32 v118, v118
    v_exp_f32 v119, v119
    v_add_f32 v200, v200, v116
    v_add_f32 v201, v201, v117
    v_add_f32 v202, v202, v118
    v_add_f32 v203, v203, v119
    v_cvt_pk_bf16_f32 v58, v116, v117
    v_cvt_pk_bf16_f32 v59, v118, v119
    v_fma_f32 v120, v120, s32, -v199
    v_fma_f32 v121, v121, s32, -v199
    v_fma_f32 v122, v122, s32, -v199
    v_fma_f32 v123, v123, s32, -v199
    v_exp_f32 v120, v120
    v_exp_f32 v121, v121
    v_exp_f32 v122, v122
    v_exp_f32 v123, v123
    v_add_f32 v200, v200, v120
    v_add_f32 v201, v201, v121
    v_add_f32 v202, v202, v122
    v_add_f32 v203, v203, v123
    v_cvt_pk_bf16_f32 v60, v120, v121
    v_cvt_pk_bf16_f32 v61, v122, v123
    v_fma_f32 v124, v124, s32, -v199
    v_fma_f32 v125, v125, s32, -v199
    v_fma_f32 v126, v126, s32, -v199
    v_fma_f32 v127, v127, s32, -v199
    v_exp_f32 v124, v124
    v_exp_f32 v125, v125
    v_exp_f32 v126, v126
    v_exp_f32 v127, v127
    v_add_f32 v200, v200, v124
    v_add_f32 v201, v201, v125
    v_add_f32 v202, v202, v126
    v_add_f32 v203, v203, v127
    v_cvt_pk_bf16_f32 v62, v124, v125
    v_cvt_pk_bf16_f32 v63, v126, v127
    v_add_f32 v200, v200, v201
    v_add_f32 v202, v202, v203
    v_add_f32 v200, v200, v202
    v_mov_b32 v198, v200
    s_nop 1
    v_permlane32_swap_b32 v200, v198
    v_add_f32 v200, v200, v198
    v_rcp_f32 v204, v200
    ds_read_b64_tr_b16 v[160:161], v193 offset:0
    ds_read_b64_tr_b16 v[162:163], v193 offset:2560
    ds_read_b64_tr_b16 v[164:165], v193 offset:64
    ds_read_b64_tr_b16 v[166:167], v193 offset:2624
    ds_read_b64_tr_b16 v[168:169], v193 offset:128
    ds_read_b64_tr_b16 v[170:171], v193 offset:2688
    ds_read_b64_tr_b16 v[172:173], v193 offset:192
    ds_read_b64_tr_b16 v[174:175], v193 offset:2752
    ds_read_b64_tr_b16 v[176:177], v193 offset:5120
    ds_read_b64_tr_b16 v[178:179], v193 offset:7680
    s_waitcnt lgkmcnt(8)
    v_mfma_f32_32x32x16_bf16 v[64:79], v[160:163], v[0:3], 0
    ds_read_b64_tr_b16 v[180:181], v193 offset:5184
    ds_read_b64_tr_b16 v[182:183], v193 offset:7744
    s_waitcnt lgkmcnt(8)
    v_mfma_f32_32x32x16_bf16 v[80:95], v[164:167], v[0:3], 0
    ds_read_b64_tr_b16 v[184:185], v193 offset:5248
    ds_read_b64_tr_b16 v[186:187], v193 offset:7808
    s_waitcnt lgkmcnt(8)
    v_mfma_f32_32x32x16_bf16 v[96:111], v[168:171], v[0:3], 0
    ds_read_b64_tr_b16 v[188:189], v193 offset:5312
    ds_read_b64_tr_b16 v[190:191], v193 offset:7872
    s_waitcnt lgkmcnt(8)
    v_mfma_f32_32x32x16_bf16 v[112:127], v[172:175], v[0:3], 0
    ds_read_b64_tr_b16 v[160:161], v193 offset:10240
    ds_read_b64_tr_b16 v[162:163], v193 offset:12800
    s_waitcnt lgkmcnt(8)
    v_mfma_f32_32x32x16_bf16 v[64:79], v[176:179], v[4:7], v[64:79]
    ds_read_b64_tr_b16 v[164:165], v193 offset:10304
    ds_read_b64_tr_b16 v[166:167], v193 offset:12864
    s_waitcnt lgkmcnt(8)
    v_mfma_f32_32x32x16_bf16 v[80:95], v[180:183], v[4:7], v[80:95]
    ds_read_b64_tr_b16 v[168:169], v193 offset:10368
    ds_read_b64_tr_b16 v[170:171], v193 offset:12928
    s_waitcnt lgkmcnt(8)
    v_mfma_f32_32x32x16_bf16 v[96:111], v[184:187], v[4:7], v[96:111]
    ds_read_b64_tr_b16 v[172:173], v193 offset:10432
    ds_read_b64_tr_b16 v[174:175], v193 offset:12992
    s_waitcnt lgkmcnt(8)
    v_mfma_f32_32x32x16_bf16 v[112:127], v[188:191], v[4:7], v[112:127]
    ds_read_b64_tr_b16 v[176:177], v193 offset:15360
    ds_read_b64_tr_b16 v[178:179], v193 offset:17920
    s_waitcnt lgkmcnt(8)
    v_mfma_f32_32x32x16_bf16 v[64:79], v[160:163], v[8:11], v[64:79]
    ds_read_b64_tr_b16 v[180:181], v193 offset:15424
    ds_read_b64_tr_b16 v[182:183], v193 offset:17984
    s_waitcnt lgkmcnt(8)
    v_mfma_f32_32x32x16_bf16 v[80:95], v[164:167], v[8:11], v[80:95]
    ds_read_b64_tr_b16 v[184:185], v193 offset:15488
    ds_read_b64_tr_b16 v[186:187], v193 offset:18048
    s_waitcnt lgkmcnt(8)
    v_mfma_f32_32x32x16_bf16 v[96:111], v[168:171], v[8:11], v[96:111]
    ds_read_b64_tr_b16 v[188:189], v193 offset:15552
    ds_read_b64_tr_b16 v[190:191], v193 offset:18112
    s_waitcnt lgkmcnt(8)
    v_mfma_f32_32x32x16_bf16 v[112:127], v[172:175], v[8:11], v[112:127]
    ds_read_b64_tr_b16 v[160:161], v193 offset:20480
    ds_read_b64_tr_b16 v[162:163], v193 offset:23040
    s_waitcnt lgkmcnt(8)
    v_mfma_f32_32x32x16_bf16 v[64:79], v[176:179], v[12:15], v[64:79]
    ds_read_b64_tr_b16 v[164:165], v193 offset:20544
    ds_read_b64_tr_b16 v[166:167], v193 offset:23104
    s_waitcnt lgkmcnt(8)
    v_mfma_f32_32x32x16_bf16 v[80:95], v[180:183], v[12:15], v[80:95]
    ds_read_b64_tr_b16 v[168:169], v193 offset:20608
    ds_read_b64_tr_b16 v[170:171], v193 offset:23168
    s_waitcnt lgkmcnt(8)
    v_mfma_f32_32x32x16_bf16 v[96:111], v[184:187], v[12:15], v[96:111]
    ds_read_b64_tr_b16 v[172:173], v193 offset:20672
    ds_read_b64_tr_b16 v[174:175], v193 offset:23232
    s_waitcnt lgkmcnt(8)
    v_mfma_f32_32x32x16_bf16 v[112:127], v[188:191], v[12:15], v[112:127]
    ds_read_b64_tr_b16 v[176:177], v193 offset:25600
    ds_read_b64_tr_b16 v[178:179], v193 offset:28160
    s_waitcnt lgkmcnt(8)
    v_mfma_f32_32x32x16_bf16 v[64:79], v[160:163], v[16:19], v[64:79]
    ds_read_b64_tr_b16 v[180:181], v193 offset:25664
    ds_read_b64_tr_b16 v[182:183], v193 offset:28224
    s_waitcnt lgkmcnt(8)
    v_mfma_f32_32x32x16_bf16 v[80:95], v[164:167], v[16:19], v[80:95]
    ds_read_b64_tr_b16 v[184:185], v193 offset:25728
    ds_read_b64_tr_b16 v[186:187], v193 offset:28288
    s_waitcnt lgkmcnt(8)
    v_mfma_f32_32x32x16_bf16 v[96:111], v[168:171], v[16:19], v[96:111]
    ds_read_b64_tr_b16 v[188:189], v193 offset:25792
    ds_read_b64_tr_b16 v[190:191], v193 offset:28352
    s_waitcnt lgkmcnt(8)
    v_mfma_f32_32x32x16_bf16 v[112:127], v[172:175], v[16:19], v[112:127]
    ds_read_b64_tr_b16 v[160:161], v193 offset:30720
    ds_read_b64_tr_b16 v[162:163], v193 offset:33280
    s_waitcnt lgkmcnt(8)
    v_mfma_f32_32x32x16_bf16 v[64:79], v[176:179], v[20:23], v[64:79]
    ds_read_b64_tr_b16 v[164:165], v193 offset:30784
    ds_read_b64_tr_b16 v[166:167], v193 offset:33344
    s_waitcnt lgkmcnt(8)
    v_mfma_f32_32x32x16_bf16 v[80:95], v[180:183], v[20:23], v[80:95]
    ds_read_b64_tr_b16 v[168:169], v193 offset:30848
    ds_read_b64_tr_b16 v[170:171], v193 offset:33408
    s_waitcnt lgkmcnt(8)
    v_mfma_f32_32x32x16_bf16 v[96:111], v[184:187], v[20:23], v[96:111]
    ds_read_b64_tr_b16 v[172:173], v193 offset:30912
    ds_read_b64_tr_b16 v[174:175], v193 offset:33472
    s_waitcnt lgkmcnt(8)
    v_mfma_f32_32x32x16_bf16 v[112:127], v[188:191], v[20:23], v[112:127]
    ds_read_b64_tr_b16 v[176:177], v193 offset:35840
    ds_read_b64_tr_b16 v[178:179], v193 offset:38400
    s_waitcnt lgkmcnt(8)
    v_mfma_f32_32x32x16_bf16 v[64:79], v[160:163], v[24:27], v[64:79]
    ds_read_b64_tr_b16 v[180:181], v193 offset:35904
    ds_read_b64_tr_b16 v[182:183], v193 offset:38464
    s_waitcnt lgkmcnt(8)
    v_mfma_f32_32x32x16_bf16 v[80:95], v[164:167], v[24:27], v[80:95]
    ds_read_b64_tr_b16 v[184:185], v193 offset:35968
    ds_read_b64_tr_b16 v[186:187], v193 offset:38528
    s_waitcnt lgkmcnt(8)
    v_mfma_f32_32x32x16_bf16 v[96:111], v[168:171], v[24:27], v[96:111]
    ds_read_b64_tr_b16 v[188:189], v193 offset:36032
    ds_read_b64_tr_b16 v[190:191], v193 offset:38592
    s_waitcnt lgkmcnt(8)
    v_mfma_f32_32x32x16_bf16 v[112:127], v[172:175], v[24:27], v[112:127]
    ds_read_b64_tr_b16 v[160:161], v194 offset:0
    ds_read_b64_tr_b16 v[162:163], v194 offset:2560
    s_waitcnt lgkmcnt(8)
    v_mfma_f32_32x32x16_bf16 v[64:79], v[176:179], v[28:31], v[64:79]
    ds_read_b64_tr_b16 v[164:165], v194 offset:64
    ds_read_b64_tr_b16 v[166:167], v194 offset:2624
    s_waitcnt lgkmcnt(8)
    v_mfma_f32_32x32x16_bf16 v[80:95], v[180:183], v[28:31], v[80:95]
    ds_read_b64_tr_b16 v[168:169], v194 offset:128
    ds_read_b64_tr_b16 v[170:171], v194 offset:2688
    s_waitcnt lgkmcnt(8)
    v_mfma_f32_32x32x16_bf16 v[96:111], v[184:187], v[28:31], v[96:111]
    ds_read_b64_tr_b16 v[172:173], v194 offset:192
    ds_read_b64_tr_b16 v[174:175], v194 offset:2752
    s_waitcnt lgkmcnt(8)
    v_mfma_f32_32x32x16_bf16 v[112:127], v[188:191], v[28:31], v[112:127]
    ds_read_b64_tr_b16 v[176:177], v194 offset:5120
    ds_read_b64_tr_b16 v[178:179], v194 offset:7680
    s_waitcnt lgkmcnt(8)
    v_mfma_f32_32x32x16_bf16 v[64:79], v[160:163], v[32:35], v[64:79]
    ds_read_b64_tr_b16 v[180:181], v194 offset:5184
    ds_read_b64_tr_b16 v[182:183], v194 offset:7744
    s_waitcnt lgkmcnt(8)
    v_mfma_f32_32x32x16_bf16 v[80:95], v[164:167], v[32:35], v[80:95]
    ds_read_b64_tr_b16 v[184:185], v194 offset:5248
    ds_read_b64_tr_b16 v[186:187], v194 offset:7808
    s_waitcnt lgkmcnt(8)
    v_mfma_f32_32x32x16_bf16 v[96:111], v[168:171], v[32:35], v[96:111]
    ds_read_b64_tr_b16 v[188:189], v194 offset:5312
    ds_read_b64_tr_b16 v[190:191], v194 offset:7872
    s_waitcnt lgkmcnt(8)
    v_mfma_f32_32x32x16_bf16 v[112:127], v[172:175], v[32:35], v[112:127]
    ds_read_b64_tr_b16 v[160:161], v194 offset:10240
    ds_read_b64_tr_b16 v[162:163], v194 offset:12800
    s_waitcnt lgkmcnt(8)
    v_mfma_f32_32x32x16_bf16 v[64:79], v[176:179], v[36:39], v[64:79]
    ds_read_b64_tr_b16 v[164:165], v194 offset:10304
    ds_read_b64_tr_b16 v[166:167], v194 offset:12864
    s_waitcnt lgkmcnt(8)
    v_mfma_f32_32x32x16_bf16 v[80:95], v[180:183], v[36:39], v[80:95]
    ds_read_b64_tr_b16 v[168:169], v194 offset:10368
    ds_read_b64_tr_b16 v[170:171], v194 offset:12928
    s_waitcnt lgkmcnt(8)
    v_mfma_f32_32x32x16_bf16 v[96:111], v[184:187], v[36:39], v[96:111]
    ds_read_b64_tr_b16 v[172:173], v194 offset:10432
    ds_read_b64_tr_b16 v[174:175], v194 offset:12992
    s_waitcnt lgkmcnt(8)
    v_mfma_f32_32x32x16_bf16 v[112:127], v[188:191], v[36:39], v[112:127]
    ds_read_b64_tr_b16 v[176:177], v194 offset:15360
    ds_read_b64_tr_b16 v[178:179], v194 offset:17920
    s_waitcnt lgkmcnt(8)
    v_mfma_f32_32x32x16_bf16 v[64:79], v[160:163], v[40:43], v[64:79]
    ds_read_b64_tr_b16 v[180:181], v194 offset:15424
    ds_read_b64_tr_b16 v[182:183], v194 offset:17984
    s_waitcnt lgkmcnt(8)
    v_mfma_f32_32x32x16_bf16 v[80:95], v[164:167], v[40:43], v[80:95]
    ds_read_b64_tr_b16 v[184:185], v194 offset:15488
    ds_read_b64_tr_b16 v[186:187], v194 offset:18048
    s_waitcnt lgkmcnt(8)
    v_mfma_f32_32x32x16_bf16 v[96:111], v[168:171], v[40:43], v[96:111]
    ds_read_b64_tr_b16 v[188:189], v194 offset:15552
    ds_read_b64_tr_b16 v[190:191], v194 offset:18112
    s_waitcnt lgkmcnt(8)
    v_mfma_f32_32x32x16_bf16 v[112:127], v[172:175], v[40:43], v[112:127]
    ds_read_b64_tr_b16 v[160:161], v194 offset:20480
    ds_read_b64_tr_b16 v[162:163], v194 offset:23040
    s_waitcnt lgkmcnt(8)
    v_mfma_f32_32x32x16_bf16 v[64:79], v[176:179], v[44:47], v[64:79]
    ds_read_b64_tr_b16 v[164:165], v194 offset:20544
    ds_read_b64_tr_b16 v[166:167], v194 offset:23104
    s_waitcnt lgkmcnt(8)
    v_mfma_f32_32x32x16_bf16 v[80:95], v[180:183], v[44:47], v[80:95]
    ds_read_b64_tr_b16 v[168:169], v194 offset:20608
    ds_read_b64_tr_b16 v[170:171], v194 offset:23168
    s_waitcnt lgkmcnt(8)
    v_mfma_f32_32x32x16_bf16 v[96:111], v[184:187], v[44:47], v[96:111]
    ds_read_b64_tr_b16 v[172:173], v194 offset:20672
    ds_read_b64_tr_b16 v[174:175], v194 offset:23232
    s_waitcnt lgkmcnt(8)
    v_mfma_f32_32x32x16_bf16 v[112:127], v[188:191], v[44:47], v[112:127]
    ds_read_b64_tr_b16 v[176:177], v194 offset:25600
    ds_read_b64_tr_b16 v[178:179], v194 offset:28160
    s_waitcnt lgkmcnt(8)
    v_mfma_f32_32x32x16_bf16 v[64:79], v[160:163], v[48:51], v[64:79]
    ds_read_b64_tr_b16 v[180:181], v194 offset:25664
    ds_read_b64_tr_b16 v[182:183], v194 offset:28224
    s_waitcnt lgkmcnt(8)
    v_mfma_f32_32x32x16_bf16 v[80:95], v[164:167], v[48:51], v[80:95]
    ds_read_b64_tr_b16 v[184:185], v194 offset:25728
    ds_read_b64_tr_b16 v[186:187], v194 offset:28288
    s_waitcnt lgkmcnt(8)
    v_mfma_f32_32x32x16_bf16 v[96:111], v[168:171], v[48:51], v[96:111]
    ds_read_b64_tr_b16 v[188:189], v194 offset:25792
    ds_read_b64_tr_b16 v[190:191], v194 offset:28352
    s_waitcnt lgkmcnt(8)
    v_mfma_f32_32x32x16_bf16 v[112:127], v[172:175], v[48:51], v[112:127]
    ds_read_b64_tr_b16 v[160:161], v194 offset:30720
    ds_read_b64_tr_b16 v[162:163], v194 offset:33280
    s_waitcnt lgkmcnt(8)
    v_mfma_f32_32x32x16_bf16 v[64:79], v[176:179], v[52:55], v[64:79]
    ds_read_b64_tr_b16 v[164:165], v194 offset:30784
    ds_read_b64_tr_b16 v[166:167], v194 offset:33344
    s_waitcnt lgkmcnt(8)
    v_mfma_f32_32x32x16_bf16 v[80:95], v[180:183], v[52:55], v[80:95]
    ds_read_b64_tr_b16 v[168:169], v194 offset:30848
    ds_read_b64_tr_b16 v[170:171], v194 offset:33408
    s_waitcnt lgkmcnt(8)
    v_mfma_f32_32x32x16_bf16 v[96:111], v[184:187], v[52:55], v[96:111]
    ds_read_b64_tr_b16 v[172:173], v194 offset:30912
    ds_read_b64_tr_b16 v[174:175], v194 offset:33472
    s_waitcnt lgkmcnt(8)
    v_mfma_f32_32x32x16_bf16 v[112:127], v[188:191], v[52:55], v[112:127]
    ds_read_b64_tr_b16 v[176:177], v194 offset:35840
    ds_read_b64_tr_b16 v[178:179], v194 offset:38400
    s_waitcnt lgkmcnt(8)
    v_mfma_f32_32x32x16_bf16 v[64:79], v[160:163], v[56:59], v[64:79]
    ds_read_b64_tr_b16 v[180:181], v194 offset:35904
    ds_read_b64_tr_b16 v[182:183], v194 offset:38464
    s_waitcnt lgkmcnt(8)
    v_mfma_f32_32x32x16_bf16 v[80:95], v[164:167], v[56:59], v[80:95]
    ds_read_b64_tr_b16 v[184:185], v194 offset:35968
    ds_read_b64_tr_b16 v[186:187], v194 offset:38528
    s_waitcnt lgkmcnt(8)
    v_mfma_f32_32x32x16_bf16 v[96:111], v[168:171], v[56:59], v[96:111]
    ds_read_b64_tr_b16 v[188:189], v194 offset:36032
    ds_read_b64_tr_b16 v[190:191], v194 offset:38592
    s_waitcnt lgkmcnt(8)
    v_mfma_f32_32x32x16_bf16 v[112:127], v[172:175], v[56:59], v[112:127]
    s_waitcnt lgkmcnt(6)
    v_mfma_f32_32x32x16_bf16 v[64:79], v[176:179], v[60:63], v[64:79]
    s_waitcnt lgkmcnt(4)
    v_mfma_f32_32x32x16_bf16 v[80:95], v[180:183], v[60:63], v[80:95]
    s_waitcnt lgkmcnt(2)
    v_mfma_f32_32x32x16_bf16 v[96:111], v[184:187], v[60:63], v[96:111]
    s_waitcnt lgkmcnt(0)
    v_mfma_f32_32x32x16_bf16 v[112:127], v[188:191], v[60:63], v[112:127]
    s_nop 15
    v_mul_f32 v64, v64, v204
    v_mul_f32 v65, v65, v204
    v_mul_f32 v66, v66, v204
    v_mul_f32 v67, v67, v204
    v_mul_f32 v68, v68, v204
    v_mul_f32 v69, v69, v204
    v_mul_f32 v70, v70, v204
    v_mul_f32 v71, v71, v204
    v_cvt_pk_bf16_f32 v212, v64, v65
    v_cvt_pk_bf16_f32 v213, v66, v67
    v_cvt_pk_bf16_f32 v214, v68, v69
    v_cvt_pk_bf16_f32 v215, v70, v71
    s_nop 1
    v_permlane32_swap_b32 v212, v214
    v_permlane32_swap_b32 v213, v215
    buffer_store_dwordx4 v[212:215], v195, s[24:27], s31 offen offset:0
    v_mul_f32 v72, v72, v204
    v_mul_f32 v73, v73, v204
    v_mul_f32 v74, v74, v204
    v_mul_f32 v75, v75, v204
    v_mul_f32 v76, v76, v204
    v_mul_f32 v77, v77, v204
    v_mul_f32 v78, v78, v204
    v_mul_f32 v79, v79, v204
    v_cvt_pk_bf16_f32 v216, v72, v73
    v_cvt_pk_bf16_f32 v217, v74, v75
    v_cvt_pk_bf16_f32 v218, v76, v77
    v_cvt_pk_bf16_f32 v219, v78, v79
    s_nop 1
    v_permlane32_swap_b32 v216, v218
    v_permlane32_swap_b32 v217, v219
    buffer_store_dwordx4 v[216:219], v195, s[24:27], s31 offen offset:32
    v_mul_f32 v80, v80, v204
    v_mul_f32 v81, v81, v204
    v_mul_f32 v82, v82, v204
    v_mul_f32 v83, v83, v204
    v_mul_f32 v84, v84, v204
    v_mul_f32 v85, v85, v204
    v_mul_f32 v86, v86, v204
    v_mul_f32 v87, v87, v204
    v_cvt_pk_bf16_f32 v220, v80, v81
    v_cvt_pk_bf16_f32 v221, v82, v83
    v_cvt_pk_bf16_f32 v222, v84, v85
    v_cvt_pk_bf16_f32 v223, v86, v87
    s_nop 1
    v_permlane32_swap_b32 v220, v222
    v_permlane32_swap_b32 v221, v223
    buffer_store_dwordx4 v[220:223], v195, s[24:27], s31 offen offset:64
    v_mul_f32 v88, v88, v204
    v_mul_f32 v89, v89, v204
    v_mul_f32 v90, v90, v204
    v_mul_f32 v91, v91, v204
    v_mul_f32 v92, v92, v204
    v_mul_f32 v93, v93, v204
    v_mul_f32 v94, v94, v204
    v_mul_f32 v95, v95, v204
    v_cvt_pk_bf16_f32 v224, v88, v89
    v_cvt_pk_bf16_f32 v225, v90, v91
    v_cvt_pk_bf16_f32 v226, v92, v93
    v_cvt_pk_bf16_f32 v227, v94, v95
    s_nop 1
    v_permlane32_swap_b32 v224, v226
    v_permlane32_swap_b32 v225, v227
    buffer_store_dwordx4 v[224:227], v195, s[24:27], s31 offen offset:96
    v_mul_f32 v96, v96, v204
    v_mul_f32 v97, v97, v204
    v_mul_f32 v98, v98, v204
    v_mul_f32 v99, v99, v204
    v_mul_f32 v100, v100, v204
    v_mul_f32 v101, v101, v204
    v_mul_f32 v102, v102, v204
    v_mul_f32 v103, v103, v204
    v_cvt_pk_bf16_f32 v228, v96, v97
    v_cvt_pk_bf16_f32 v229, v98, v99
    v_cvt_pk_bf16_f32 v230, v100, v101
    v_cvt_pk_bf16_f32 v231, v102, v103
    s_nop 1
    v_permlane32_swap_b32 v228, v230
    v_permlane32_swap_b32 v229, v231
    buffer_store_dwordx4 v[228:231], v195, s[24:27], s31 offen offset:128
    v_mul_f32 v104, v104, v204
    v_mul_f32 v105, v105, v204
    v_mul_f32 v106, v106, v204
    v_mul_f32 v107, v107, v204
    v_mul_f32 v108, v108, v204
    v_mul_f32 v109, v109, v204
    v_mul_f32 v110, v110, v204
    v_mul_f32 v111, v111, v204
    v_cvt_pk_bf16_f32 v232, v104, v105
    v_cvt_pk_bf16_f32 v233, v106, v107
    v_cvt_pk_bf16_f32 v234, v108, v109
    v_cvt_pk_bf16_f32 v235, v110, v111
    s_nop 1
    v_permlane32_swap_b32 v232, v234
    v_permlane32_swap_b32 v233, v235
    buffer_store_dwordx4 v[232:235], v195, s[24:27], s31 offen offset:160
    v_mul_f32 v112, v112, v204
    v_mul_f32 v113, v113, v204
    v_mul_f32 v114, v114, v204
    v_mul_f32 v115, v115, v204
    v_mul_f32 v116, v116, v204
    v_mul_f32 v117, v117, v204
    v_mul_f32 v118, v118, v204
    v_mul_f32 v119, v119, v204
    v_cvt_pk_bf16_f32 v236, v112, v113
    v_cvt_pk_bf16_f32 v237, v114, v115
    v_cvt_pk_bf16_f32 v238, v116, v117
    v_cvt_pk_bf16_f32 v239, v118, v119
    s_nop 1
    v_permlane32_swap_b32 v236, v238
    v_permlane32_swap_b32 v237, v239
    buffer_store_dwordx4 v[236:239], v195, s[24:27], s31 offen offset:192
    v_mul_f32 v120, v120, v204
    v_mul_f32 v121, v121, v204
    v_mul_f32 v122, v122, v204
    v_mul_f32 v123, v123, v204
    v_mul_f32 v124, v124, v204
    v_mul_f32 v125, v125, v204
    v_mul_f32 v126, v126, v204
    v_mul_f32 v127, v127, v204
    v_cvt_pk_bf16_f32 v240, v120, v121
    v_cvt_pk_bf16_f32 v241, v122, v123
    v_cvt_pk_bf16_f32 v242, v124, v125
    v_cvt_pk_bf16_f32 v243, v126, v127
    s_nop 1
    v_permlane32_swap_b32 v240, v242
    v_permlane32_swap_b32 v241, v243
    buffer_store_dwordx4 v[240:243], v195, s[24:27], s31 offen offset:224
    s_add_u32 s29, s29, 1
    s_cmp_lt_u32 s29, 4
    s_waitcnt vmcnt(8)
    s_cbranch_scc1 L_loop
L_done:
    s_endpgm
.section .rodata,"a"
.p2align 6
.amdhsa_kernel standalone__gqa_softmax__near_ridge_kernel
  .amdhsa_next_free_vgpr 256
  .amdhsa_next_free_sgpr 48
  .amdhsa_accum_offset 256
  .amdhsa_group_segment_fixed_size 0
  .amdhsa_kernarg_size 48
  .amdhsa_user_sgpr_count 2
  .amdhsa_user_sgpr_kernarg_segment_ptr 1
  .amdhsa_system_sgpr_workgroup_id_x 1
.end_amdhsa_kernel
```
